```python
import torch

def _softmax(x, axis=-1):
    return torch.softmax(x, dim=axis)
def _gelu(x):
    return torch.nn.functional.gelu(x, approximate="tanh")
def _silu(x):
    return torch.nn.functional.silu(x)
def _sigmoid(x):
    return torch.sigmoid(x)
def _layernorm(x, axis=-1, eps=1e-5):
    m = x.mean(dim=axis, keepdim=True)
    v = x.var(dim=axis, keepdim=True, unbiased=False)
    return (x - m) / torch.sqrt(v + eps)
def _scatter_add(tgt, idx, src, axis=0):
    return tgt.clone().index_add_(axis, idx, src)
def _segment_sum(src, seg, n):
    out = torch.zeros((n,) + src.shape[1:], dtype=src.dtype)
    return out.index_add_(0, seg, src)
def _pad(x, pw):
    flat = tuple(v for pair in reversed(pw) for v in pair)
    return torch.nn.functional.pad(x, flat)

kernel_name = 'standalone__weight_only_int_omniquant__prompt'

def setup_inputs():

    _w = (lambda a: (lambda t: t.to(torch.bfloat16) if t.is_floating_point() else t)(torch.as_tensor(a)))
    B, S, D, F = 1, 2048, 1024, 3584
    bits = 8
    G = 32 if 32 > 0 else D
    D = (D // G) * G
    ng = D // G
    qmax = (1 << bits) - 1
    qw = torch.randint(0, qmax + 1, (D, F)).to(torch.int32)
    scales = (torch.abs((lambda *s: torch.randn(*s, dtype=torch.bfloat16) * 0.05)(ng, F)) * 0.05 + 0.01).to(float)
    zeros = torch.randint(0, qmax + 1, (ng, F)).to(float)
    act_scale = (torch.abs((lambda *s: torch.randn(*s, dtype=torch.bfloat16) * 0.05)(D)) * 0.5 + 0.5).to(float)
    return {
        "x": _w((lambda *s: torch.randn(*s, dtype=torch.bfloat16) * 0.05)(B, S, D)),
        "qw": _w(qw),
        "scales": _w(scales),
        "zeros": _w(zeros),
        "act_scale": _w(act_scale),
    }

def reference(x, qw, scales, zeros, act_scale):
    B, S, D = x.shape
    ng, F = scales.shape
    G = D // ng
    s = (lambda x, n, axis: torch.repeat_interleave(x, n, dim=axis))(scales, G, axis=0)
    z = (lambda x, n, axis: torch.repeat_interleave(x, n, dim=axis))(zeros, G, axis=0)
    w = ((lambda x, dt: x.to(dt))(qw, x.dtype) - z) * s
    xs = x * (lambda x, dt: x.to(dt))(act_scale, x.dtype)
    return torch.einsum("bsd,df->bsf", xs, w)
```

```asm
; @launch grid=(256,1,1) block=(512,1,1) lds=163840
.amdgcn_target "amdgcn-amd-amdhsa--gfx950"
.text
.globl standalone__weight_only_int_omniquant__prompt_kernel
.p2align 8
.type standalone__weight_only_int_omniquant__prompt_kernel,@function
standalone__weight_only_int_omniquant__prompt_kernel:
  s_cmp_ge_u32 s2, 256
  s_cbranch_scc1 L_end
  s_load_dwordx16 s[32:47], s[0:1], 0
  s_memrealtime s[60:61]
  v_lshrrev_b32 v1, 6, v0
  v_and_b32 v0, 63, v0
  v_readfirstlane_b32 s3, v1
  s_getpc_b64 s[4:5]
  v_lshlrev_b32 v2, 7, v0
  s_lshr_b32 s6, s2, 3
  s_nop 1
  s_cmp_eq_u32 s3, 4
  s_cselect_b32 s6, s6, 99
  s_cmp_lt_u32 s6, 32
  s_cbranch_scc0 L_nocpf
  v_min_u32 v2, L_code_end - L_nocpf, v2
  v_mov_b32 v3, s5
  v_add_co_u32 v2, vcc, s4, v2
  s_nop 1
  v_addc_co_u32 v3, vcc, 0, v3, vcc
  global_load_dword v47, v[2:3], off
L_nocpf:
  s_and_b32 s4, s2, 7
  s_lshr_b32 s5, s2, 3
  s_and_b32 s6, s5, 7
  s_lshr_b32 s7, s5, 3
  s_lshl_b32 s48, s6, 8
  s_lshl_b32 s71, s4, 2
  s_add_u32 s71, s71, s7
  s_mul_i32 s49, s71, 112
  s_add_u32 s50, s6, s4
  s_lshl_b32 s50, s50, 1
  s_cmp_ge_u32 s3, 4
  s_cselect_b32 s76, 1, 0
  s_and_b32 s3, s3, 3
  s_add_u32 s57, s50, s76
  s_and_b32 s57, s57, 15
  s_mul_i32 s52, s57, 917504
  s_lshl_b32 s53, s57, 7
  s_lshl_b32 s66, s57, 14
  s_mul_i32 s57, s57, 14336
  s_lshl_b32 s4, s3, 1
  v_lshrrev_b32 v2, 5, v0
  v_and_b32 v3, 31, v0
  v_subrev_u32 v5, 4, v3
  v_cmp_lt_u32 vcc, 27, v3
  v_add_u32 v4, s4, v2
  s_lshl_b32 s5, s49, 2
  v_cndmask_b32 v7, v3, v5, vcc
  s_lshl_b32 s72, s7, 2
  v_add_u32 v1, s72, v7
  v_subrev_u32 v6, 28, v1
  v_min_u32 v1, v1, v6
  v_mul_u32_u24 v5, 114688, v4
  v_lshlrev_b32 v6, 4, v1
  v_add3_u32 v32, v5, v6, s5
  v_add_u32 v33, 14336, v32
  v_add_u32 v34, 28672, v32
  v_add_u32 v35, 43008, v32
  v_add_u32 v36, 57344, v32
  v_add_u32 v37, 71680, v32
  v_add_u32 v38, 86016, v32
  v_add_u32 v39, 100352, v32
  s_lshr_b32 s5, s3, 1
  s_mul_i32 s5, s5, 7168
  s_lshl_b32 s4, s49, 1
  s_add_u32 s5, s5, s4
  v_lshl_add_u32 v40, v1, 3, s5
  v_lshlrev_b32 v41, 4, v4
  s_mul_i32 s71, s71, 0x41000
  s_add_u32 s71, s71, 0x1000000
  s_lshl_b32 s4, s3, 7
  s_add_u32 s4, s4, s71
  s_add_u32 s67, s4, 0x40000
  v_and_b32 v5, 15, v0
  v_lshl_add_u32 v43, v5, 3, s67
  s_mov_b32 s18, 229376
  s_mov_b32 s19, 0x20000
  s_mov_b32 s22, 229376
  s_mov_b32 s23, 0x20000
  s_mov_b32 s26, 2048
  s_mov_b32 s27, 0x20000
  s_mov_b32 s14, 14680064
  s_mov_b32 s15, 0x20000
  s_mov_b32 s30, 26214400
  s_mov_b32 s31, 0x20000
  s_mov_b32 s10, 4194304
  s_mov_b32 s11, 0x20000
  s_waitcnt lgkmcnt(0)
  s_mov_b32 s16, s36
  s_and_b32 s17, s37, 0xffff
  s_mov_b32 s20, s38
  s_and_b32 s21, s39, 0xffff
  s_mov_b32 s24, s40
  s_and_b32 s25, s41, 0xffff
  s_mov_b32 s12, s34
  s_and_b32 s13, s35, 0xffff
  s_mov_b32 s28, s46
  s_and_b32 s29, s47, 0xffff
  s_mov_b32 s8, s32
  s_and_b32 s9, s33, 0xffff
  s_cmp_lg_u32 s76, 0
  s_cbranch_scc1 L_nopf
  buffer_load_dwordx2 v[50:51], v43, s[28:31], 0 offen sc1
L_nopf:
  buffer_load_dwordx2 v[84:85], v40, s[16:19], s57 offen
  buffer_load_dwordx2 v[86:87], v40, s[20:23], s57 offen
  buffer_load_dwordx4 v[88:91], v41, s[24:27], s53 offen
  buffer_load_dwordx4 v[92:95], v32, s[12:15], s52 offen nt
  buffer_load_dwordx4 v[96:99], v33, s[12:15], s52 offen nt
  buffer_load_dwordx4 v[100:103], v34, s[12:15], s52 offen nt
  buffer_load_dwordx4 v[104:107], v35, s[12:15], s52 offen nt
  buffer_load_dwordx4 v[108:111], v36, s[12:15], s52 offen nt
  buffer_load_dwordx4 v[112:115], v37, s[12:15], s52 offen nt
  buffer_load_dwordx4 v[116:119], v38, s[12:15], s52 offen nt
  buffer_load_dwordx4 v[120:123], v39, s[12:15], s52 offen nt
  s_mul_i32 s4, s3, 3584
  s_add_u32 s70, s4, 0x18000
  s_add_u32 s5, s71, s4
  s_lshl_b32 s4, s76, 14
  s_add_u32 s4, s4, s70
  v_mul_u32_u24 v5, 1792, v2
  v_lshl_add_u32 v6, v7, 4, v5
  v_add_u32 v28, s4, v6
  v_add_u32 v24, s5, v6
  v_lshl_add_u32 v46, v0, 4, s5
  v_mov_b32 v42, 0xffff0000
  s_lshl_b32 s4, s6, 3
  s_add_u32 s67, s67, s4
  v_mov_b32 v140, s67
  s_getreg_b32 s4, hwreg(HW_REG_XCC_ID, 0, 4)
  s_add_u32 s4, s4, 1
  s_lshl_b32 s4, s4, 24
  v_mov_b32 v141, s4
  s_cmp_lg_u32 s76, 0
  s_cbranch_scc1 L_csetup
  v_lshrrev_b32 v5, 3, v0
  s_lshl_b32 s5, s3, 6
  s_add_u32 s5, s5, s48
  v_add_u32 v5, s5, v5
  v_lshlrev_b32 v5, 11, v5
  v_lshrrev_b32 v6, 4, v0
  v_and_b32 v7, 7, v0
  v_xor_b32 v6, v6, v7
  v_lshl_add_u32 v5, v6, 4, v5
  v_xor_b32 v6, 64, v5
  v_add_u32 v124, 0, v5
  v_add_u32 v125, 15360, v6
  v_add_u32 v126, 30720, v5
  v_add_u32 v127, 46080, v6
  v_add_u32 v128, 65536, v5
  v_add_u32 v129, 80896, v6
  v_add_u32 v130, 96256, v5
  v_add_u32 v131, 111616, v6
  s_lshl_b32 s68, s3, 13
  s_add_u32 s69, s68, 0x18000
  s_mov_b32 s56, s68
  s_sub_u32 s4, s60, 256
  s_subb_u32 s5, s61, 0
  v_mov_b32 v48, s4
  v_mov_b32 v49, s5
  s_mov_b32 s58, 0xca864210
  s_mov_b32 s59, 0xfdb9753e
  s_mov_b32 s55, 3
  s_mov_b32 s77, 6
  s_mov_b32 s78, 7
  s_mov_b32 s79, 8
  s_mov_b32 s51, 0
  s_add_u32 s57, s58, s50
  s_and_b32 s57, s57, 15
  s_lshr_b64 s[58:59], s[58:59], 4
  s_mul_i32 s52, s57, 917504
  s_lshl_b32 s54, s57, 7
  s_mul_i32 s57, s57, 14336
L_own:
  s_waitcnt vmcnt(8)
  v_lshlrev_b32 v64, 16, v84
  v_and_b32 v65, v42, v84
  v_lshlrev_b32 v80, 16, v86
  v_and_b32 v81, v42, v86
  v_lshlrev_b32 v66, 16, v85
  v_and_b32 v67, v42, v85
  v_lshlrev_b32 v82, 16, v87
  v_and_b32 v83, v42, v87
  v_lshlrev_b32 v72, 16, v88
  v_and_b32 v73, v42, v88
  v_lshlrev_b32 v74, 16, v89
  v_and_b32 v75, v42, v89
  v_lshlrev_b32 v76, 16, v90
  v_and_b32 v77, v42, v90
  v_lshlrev_b32 v78, 16, v91
  v_and_b32 v79, v42, v91
  v_mul_f32_e64 v68, -v80, v64
  v_mul_f32_e64 v69, -v81, v65
  v_mul_f32_e64 v70, -v82, v66
  v_mul_f32_e64 v71, -v83, v67
  s_waitcnt vmcnt(7)
  v_cvt_f32_i32 v92, v92
  v_cvt_f32_i32 v93, v93
  v_cvt_f32_i32 v94, v94
  v_cvt_f32_i32 v95, v95
  v_fma_f32 v92, v92, v64, v68
  v_fma_f32 v93, v93, v65, v69
  v_fma_f32 v94, v94, v66, v70
  v_fma_f32 v95, v95, v67, v71
  v_mul_f32 v92, v92, v72
  v_mul_f32 v93, v93, v72
  v_mul_f32 v94, v94, v72
  v_mul_f32 v95, v95, v72
  s_waitcnt vmcnt(6)
  v_cvt_f32_i32 v96, v96
  v_cvt_f32_i32 v97, v97
  v_cvt_f32_i32 v98, v98
  v_cvt_f32_i32 v99, v99
  v_fma_f32 v96, v96, v64, v68
  v_fma_f32 v97, v97, v65, v69
  v_fma_f32 v98, v98, v66, v70
  v_fma_f32 v99, v99, v67, v71
  v_mul_f32 v96, v96, v73
  v_mul_f32 v97, v97, v73
  v_mul_f32 v98, v98, v73
  v_mul_f32 v99, v99, v73
  v_cvt_pk_bf16_f32 v8, v92, v96
  v_cvt_pk_bf16_f32 v12, v93, v97
  v_cvt_pk_bf16_f32 v16, v94, v98
  v_cvt_pk_bf16_f32 v20, v95, v99
  s_waitcnt vmcnt(5)
  v_cvt_f32_i32 v100, v100
  v_cvt_f32_i32 v101, v101
  v_cvt_f32_i32 v102, v102
  v_cvt_f32_i32 v103, v103
  v_fma_f32 v100, v100, v64, v68
  v_fma_f32 v101, v101, v65, v69
  v_fma_f32 v102, v102, v66, v70
  v_fma_f32 v103, v103, v67, v71
  v_mul_f32 v100, v100, v74
  v_mul_f32 v101, v101, v74
  v_mul_f32 v102, v102, v74
  v_mul_f32 v103, v103, v74
  s_waitcnt vmcnt(4)
  v_cvt_f32_i32 v104, v104
  v_cvt_f32_i32 v105, v105
  v_cvt_f32_i32 v106, v106
  v_cvt_f32_i32 v107, v107
  v_fma_f32 v104, v104, v64, v68
  v_fma_f32 v105, v105, v65, v69
  v_fma_f32 v106, v106, v66, v70
  v_fma_f32 v107, v107, v67, v71
  v_mul_f32 v104, v104, v75
  v_mul_f32 v105, v105, v75
  v_mul_f32 v106, v106, v75
  v_mul_f32 v107, v107, v75
  v_cvt_pk_bf16_f32 v9, v100, v104
  v_cvt_pk_bf16_f32 v13, v101, v105
  v_cvt_pk_bf16_f32 v17, v102, v106
  v_cvt_pk_bf16_f32 v21, v103, v107
  s_waitcnt vmcnt(3)
  v_cvt_f32_i32 v108, v108
  v_cvt_f32_i32 v109, v109
  v_cvt_f32_i32 v110, v110
  v_cvt_f32_i32 v111, v111
  v_fma_f32 v108, v108, v64, v68
  v_fma_f32 v109, v109, v65, v69
  v_fma_f32 v110, v110, v66, v70
  v_fma_f32 v111, v111, v67, v71
  v_mul_f32 v108, v108, v76
  v_mul_f32 v109, v109, v76
  v_mul_f32 v110, v110, v76
  v_mul_f32 v111, v111, v76
  s_waitcnt vmcnt(2)
  v_cvt_f32_i32 v112, v112
  v_cvt_f32_i32 v113, v113
  v_cvt_f32_i32 v114, v114
  v_cvt_f32_i32 v115, v115
  v_fma_f32 v112, v112, v64, v68
  v_fma_f32 v113, v113, v65, v69
  v_fma_f32 v114, v114, v66, v70
  v_fma_f32 v115, v115, v67, v71
  v_mul_f32 v112, v112, v77
  v_mul_f32 v113, v113, v77
  v_mul_f32 v114, v114, v77
  v_mul_f32 v115, v115, v77
  v_cvt_pk_bf16_f32 v10, v108, v112
  v_cvt_pk_bf16_f32 v14, v109, v113
  v_cvt_pk_bf16_f32 v18, v110, v114
  v_cvt_pk_bf16_f32 v22, v111, v115
  s_waitcnt vmcnt(1)
  v_cvt_f32_i32 v116, v116
  v_cvt_f32_i32 v117, v117
  v_cvt_f32_i32 v118, v118
  v_cvt_f32_i32 v119, v119
  v_fma_f32 v116, v116, v64, v68
  v_fma_f32 v117, v117, v65, v69
  v_fma_f32 v118, v118, v66, v70
  v_fma_f32 v119, v119, v67, v71
  v_mul_f32 v116, v116, v78
  v_mul_f32 v117, v117, v78
  v_mul_f32 v118, v118, v78
  v_mul_f32 v119, v119, v78
  s_waitcnt vmcnt(0)
  v_cvt_f32_i32 v120, v120
  v_cvt_f32_i32 v121, v121
  v_cvt_f32_i32 v122, v122
  v_cvt_f32_i32 v123, v123
  v_fma_f32 v120, v120, v64, v68
  v_fma_f32 v121, v121, v65, v69
  v_fma_f32 v122, v122, v66, v70
  v_fma_f32 v123, v123, v67, v71
  v_mul_f32 v120, v120, v79
  v_mul_f32 v121, v121, v79
  v_mul_f32 v122, v122, v79
  v_mul_f32 v123, v123, v79
  v_cvt_pk_bf16_f32 v11, v116, v120
  ds_write_b128 v28, v[8:11] offset:0
  v_cvt_pk_bf16_f32 v15, v117, v121
  ds_write_b128 v28, v[12:15] offset:448
  v_cvt_pk_bf16_f32 v19, v118, v122
  ds_write_b128 v28, v[16:19] offset:896
  v_cvt_pk_bf16_f32 v23, v119, v123
  ds_write_b128 v28, v[20:23] offset:1344
  s_cmp_lg_u32 s76, 0
  s_cbranch_scc1 L_consumer
  buffer_store_dwordx4 v[8:11], v24, s[28:31], s66 offen offset:0
  buffer_store_dwordx4 v[12:15], v24, s[28:31], s66 offen offset:448
  buffer_store_dwordx4 v[16:19], v24, s[28:31], s66 offen offset:896
  buffer_store_dwordx4 v[20:23], v24, s[28:31], s66 offen offset:1344
  s_mov_b32 m0, s56
  s_nop 0
  buffer_load_dwordx4 v124, s[8:11], s54 offen offset:0  lds
  buffer_load_dwordx4 v125, s[8:11], s54 offen offset:1024  lds
  buffer_load_dwordx4 v126, s[8:11], s54 offen offset:2048  lds
  buffer_load_dwordx4 v127, s[8:11], s54 offen offset:3072  lds
  s_add_u32 m0, s56, 4096
  s_add_u32 s56, s56, 0x8000
  s_cmp_lt_u32 s56, s69
  s_cselect_b32 s56, s56, s68
  buffer_load_dwordx4 v128, s[8:11], s54 offen offset:0  lds
  buffer_load_dwordx4 v129, s[8:11], s54 offen offset:1024  lds
  buffer_load_dwordx4 v130, s[8:11], s54 offen offset:2048  lds
  buffer_load_dwordx4 v131, s[8:11], s54 offen offset:3072  lds
  s_waitcnt vmcnt(8)
  s_memrealtime s[74:75]
  s_waitcnt lgkmcnt(0)
  v_mov_b32 v142, s74
  v_xor_b32 v143, s75, v141
  s_mov_b64 exec, 1
  buffer_store_dwordx2 v[142:143], v140, s[28:31], 0 offen
  s_mov_b64 exec, -1
  s_add_u32 s57, s58, s50
  s_and_b32 s57, s57, 15
  s_lshr_b64 s[58:59], s[58:59], 4
  s_mul_i32 s52, s57, 917504
  s_lshl_b32 s54, s57, 7
  s_mul_i32 s57, s57, 14336
  s_mov_b32 m0, s56
  s_nop 0
  buffer_load_dwordx4 v124, s[8:11], s54 offen offset:0  lds
  buffer_load_dwordx4 v125, s[8:11], s54 offen offset:1024  lds
  buffer_load_dwordx4 v126, s[8:11], s54 offen offset:2048  lds
  buffer_load_dwordx4 v127, s[8:11], s54 offen offset:3072  lds
  s_add_u32 m0, s56, 4096
  s_add_u32 s56, s56, 0x8000
  s_cmp_lt_u32 s56, s69
  s_cselect_b32 s56, s56, s68
  buffer_load_dwordx4 v128, s[8:11], s54 offen offset:0  lds
  buffer_load_dwordx4 v129, s[8:11], s54 offen offset:1024  lds
  buffer_load_dwordx4 v130, s[8:11], s54 offen offset:2048  lds
  buffer_load_dwordx4 v131, s[8:11], s54 offen offset:3072  lds
  s_waitcnt vmcnt(9)
  s_barrier
  s_add_u32 s51, s51, 1
  v_lshlrev_b32 v45, 4, v0
  v_add_u32 v45, s70, v45
  ds_read_b128 v[92:95], v45 offset:16384
  ds_read_b128 v[96:99], v45 offset:17408
  ds_read_b128 v[100:103], v45 offset:18432
  ds_read_b128 v[104:107], v45 offset:19456
  s_add_u32 s66, s66, 0x4000
  buffer_load_dwordx2 v[50:51], v43, s[28:31], 0 offen sc1
  s_add_u32 s57, s58, s50
  s_and_b32 s57, s57, 15
  s_lshr_b64 s[58:59], s[58:59], 4
  s_mul_i32 s52, s57, 917504
  s_lshl_b32 s54, s57, 7
  s_mul_i32 s57, s57, 14336
  s_mov_b32 m0, s56
  s_nop 0
  buffer_load_dwordx4 v124, s[8:11], s54 offen offset:0  lds
  buffer_load_dwordx4 v125, s[8:11], s54 offen offset:1024  lds
  buffer_load_dwordx4 v126, s[8:11], s54 offen offset:2048  lds
  buffer_load_dwordx4 v127, s[8:11], s54 offen offset:3072  lds
  s_add_u32 m0, s56, 4096
  s_add_u32 s56, s56, 0x8000
  s_cmp_lt_u32 s56, s69
  s_cselect_b32 s56, s56, s68
  buffer_load_dwordx4 v128, s[8:11], s54 offen offset:0  lds
  buffer_load_dwordx4 v129, s[8:11], s54 offen offset:1024  lds
  buffer_load_dwordx4 v130, s[8:11], s54 offen offset:2048  lds
  buffer_load_dwordx4 v131, s[8:11], s54 offen offset:3072  lds
  s_waitcnt vmcnt(8)
  v_sub_co_u32 v52, vcc, v50, v48
  v_xor_b32 v53, v51, v141
  s_nop 0
  v_subb_co_u32 v53, vcc, v53, v49, vcc
  v_lshrrev_b32 v52, 24, v52
  v_or_b32 v52, v52, v53
  v_cmp_ne_u32 vcc, 0, v52
  s_nop 4
  s_and_b32 s4, vcc_lo, 0xff
  s_cbranch_scc1 L_late0
  s_add_u32 s4, s51, 1
  s_and_b32 s4, s4, 3
  s_lshl_b32 s4, s4, 14
  s_add_u32 m0, s4, s70
  s_lshl_b32 s5, s54, 7
  buffer_load_dwordx4 v46, s[28:31], s5 offen offset:0 sc1 lds
  buffer_load_dwordx4 v46, s[28:31], s5 offen offset:1024 sc1 lds
  buffer_load_dwordx4 v46, s[28:31], s5 offen offset:2048 sc1 lds
  s_mov_b32 exec_hi, 0
  buffer_load_dwordx4 v46, s[28:31], s5 offen offset:3072 sc1 lds
  s_mov_b32 exec_hi, -1
  s_barrier
  s_add_u32 s51, s51, 1
L_floop:
  s_add_u32 s57, s58, s50
  s_and_b32 s57, s57, 15
  s_lshr_b64 s[58:59], s[58:59], 4
  s_mul_i32 s52, s57, 917504
  s_lshl_b32 s54, s57, 7
  s_mul_i32 s57, s57, 14336
  s_cmp_eq_u32 s51, s77
  s_cbranch_scc1 L_ev_flag
  s_cmp_eq_u32 s51, s78
  s_cbranch_scc1 L_ev_poll
  s_cmp_eq_u32 s51, s79
  s_cbranch_scc1 L_ev_chk
L_ev_back:
  s_add_u32 s4, s51, 1
  s_and_b32 s4, s4, 3
  s_lshl_b32 s4, s4, 14
  s_add_u32 m0, s4, s70
  s_lshl_b32 s5, s54, 7
  buffer_load_dwordx4 v46, s[28:31], s5 offen offset:0 sc1 lds
  buffer_load_dwordx4 v46, s[28:31], s5 offen offset:1024 sc1 lds
  buffer_load_dwordx4 v46, s[28:31], s5 offen offset:2048 sc1 lds
  s_mov_b32 exec_hi, 0
  buffer_load_dwordx4 v46, s[28:31], s5 offen offset:3072 sc1 lds
  s_mov_b32 exec_hi, -1
  s_mov_b32 m0, s56
  s_nop 0
  buffer_load_dwordx4 v124, s[8:11], s54 offen offset:0  lds
  buffer_load_dwordx4 v125, s[8:11], s54 offen offset:1024  lds
  buffer_load_dwordx4 v126, s[8:11], s54 offen offset:2048  lds
  buffer_load_dwordx4 v127, s[8:11], s54 offen offset:3072  lds
  s_add_u32 m0, s56, 4096
  s_add_u32 s56, s56, 0x8000
  s_cmp_lt_u32 s56, s69
  s_cselect_b32 s56, s56, s68
  buffer_load_dwordx4 v128, s[8:11], s54 offen offset:0  lds
  buffer_load_dwordx4 v129, s[8:11], s54 offen offset:1024  lds
  buffer_load_dwordx4 v130, s[8:11], s54 offen offset:2048  lds
  buffer_load_dwordx4 v131, s[8:11], s54 offen offset:3072  lds
  s_cmp_eq_u32 s51, s55
  s_cbranch_scc1 L_ev_store
  s_waitcnt vmcnt(12)
L_ev_store_back:
  s_barrier
  s_add_u32 s51, s51, 1
  s_cmp_lt_u32 s51, 15
  s_cbranch_scc1 L_floop
L_flast:
  s_waitcnt vmcnt(0)
  s_barrier
  s_add_u32 s51, s51, 1
L_pend:
  s_lshl_b32 s4, s3, 6
  s_lshl_b32 s5, s3, 13
  s_add_u32 s5, s5, 0x8000
  s_lshl_b32 s72, s7, 1
  s_add_u32 s72, s72, 8
  s_add_u32 s4, s4, s48
  s_lshl_b32 s73, s49, 1
  v_min_u32 v59, 47, v0
  v_mul_u32_u24 v57, 10923, v59
  v_lshrrev_b32 v57, 16, v57
  v_mul_u32_u24 v58, 6, v57
  v_sub_u32 v58, v59, v58
  v_mul_u32_u24 v127, 240, v57
  v_lshl_add_u32 v127, v58, 4, v127
  v_add_u32 v127, s5, v127
  v_add_u32 v58, s72, v58
  v_subrev_u32 v59, 14, v58
  v_min_u32 v58, v58, v59
  v_add_u32 v143, s4, v57
  v_mul_u32_u24 v143, 7168, v143
  v_lshl_add_u32 v143, v58, 4, v143
  v_cmp_lt_u32 vcc, 47, v0
  v_add_u32 v143, s73, v143
  v_mov_b32 v57, 0x40000000
  v_cndmask_b32 v143, v143, v57, vcc
  v_lshrrev_b32 v57, 4, v0
  v_lshl_add_u32 v139, v57, 2, s4
  v_mul_u32_u24 v139, 7168, v139
  v_and_b32 v57, 15, v0
  v_lshl_add_u32 v139, v57, 3, v139
  s_lshl_b32 s72, s7, 5
  s_add_u32 s73, s73, s72
  v_add_u32 v139, s73, v139
  s_mov_b32 s8, s42
  s_and_b32 s9, s43, 0xffff
  s_mov_b32 s10, 14680064
  s_mov_b32 s11, 0x20000
  s_barrier
  ds_read_b128 v[160:163], v127 offset:128
  ds_read_b128 v[164:167], v127 offset:2048
  s_mov_b32 s4, 0
  s_waitcnt lgkmcnt(1)
  buffer_store_dwordx4 v[160:163], v143, s[8:11], s4 offen nt
  s_mov_b32 s4, 57344
  s_waitcnt lgkmcnt(0)
  buffer_store_dwordx4 v[164:167], v143, s[8:11], s4 offen nt
  s_barrier
  ds_read_b128 v[176:179], v127 offset:3968
  ds_read_b128 v[180:183], v127 offset:5888
  s_mov_b32 s4, 114688
  s_waitcnt lgkmcnt(1)
  buffer_store_dwordx4 v[176:179], v143, s[8:11], s4 offen
  s_mov_b32 s4, 172032
  s_waitcnt lgkmcnt(0)
  buffer_store_dwordx4 v[180:183], v143, s[8:11], s4 offen
  s_barrier
  ds_read_b128 v[192:195], v127 offset:32896
  ds_read_b128 v[196:199], v127 offset:34816
  s_mov_b32 s4, 229376
  s_waitcnt lgkmcnt(1)
  buffer_store_dwordx4 v[192:195], v143, s[8:11], s4 offen
  s_mov_b32 s4, 286720
  s_waitcnt lgkmcnt(0)
  buffer_store_dwordx4 v[196:199], v143, s[8:11], s4 offen
L_end:
  s_endpgm
L_ev_store:
  s_waitcnt lgkmcnt(0)
  s_cmp_lg_u32 s51, 3
  s_cbranch_scc1 L_ev_st1
  s_add_u32 s55, s55, 1
  buffer_store_dwordx4 v[92:95], v46, s[28:31], s66 offen offset:0 sc1
  buffer_store_dwordx4 v[96:99], v46, s[28:31], s66 offen offset:1024 sc1
  s_waitcnt vmcnt(14)
  s_branch L_ev_store_back
L_ev_st1:
  buffer_store_dwordx4 v[100:103], v46, s[28:31], s66 offen offset:2048 sc1
  s_mov_b32 exec_hi, 0
  buffer_store_dwordx4 v[104:107], v46, s[28:31], s66 offen offset:3072 sc1
  s_mov_b32 exec_hi, -1
  s_waitcnt vmcnt(14)
  s_branch L_ev_store_back
L_ev_flag:
  s_memrealtime s[74:75]
  s_waitcnt lgkmcnt(0)
  v_mov_b32 v142, s74
  v_xor_b32 v143, s75, v141
  s_mov_b64 exec, 1
  buffer_store_dwordx2 v[142:143], v140, s[28:31], 0 offen offset:64
  s_mov_b64 exec, -1
  s_branch L_ev_back
L_ev_poll:
  buffer_load_dwordx2 v[50:51], v43, s[28:31], 0 offen sc1
  s_mov_b32 s73, 0
  s_branch L_ev_back
L_ev_chk:
  v_sub_co_u32 v52, vcc, v50, v48
  v_xor_b32 v53, v51, v141
  s_nop 0
  v_subb_co_u32 v53, vcc, v53, v49, vcc
  v_lshrrev_b32 v52, 24, v52
  v_or_b32 v52, v52, v53
  v_cmp_ne_u32 vcc, 0, v52
  s_nop 4
  s_and_b32 s4, vcc_lo, 0xffff
  s_cbranch_scc0 L_ev_back
  s_add_u32 s73, s73, 1
  s_cmp_gt_u32 s73, 120
  s_cbranch_scc1 L_fb1
  buffer_load_dwordx2 v[50:51], v43, s[28:31], 0 offen sc1
  s_waitcnt vmcnt(0)
  s_branch L_ev_chk
L_late0:
  s_barrier
  s_add_u32 s51, s51, 1
  s_mov_b32 s73, 0
L_chk0:
  buffer_load_dwordx2 v[50:51], v43, s[28:31], 0 offen sc1
L_chk0b:
  s_waitcnt vmcnt(0)
  v_sub_co_u32 v52, vcc, v50, v48
  v_xor_b32 v53, v51, v141
  s_nop 0
  v_subb_co_u32 v53, vcc, v53, v49, vcc
  v_lshrrev_b32 v52, 24, v52
  v_or_b32 v52, v52, v53
  v_cmp_ne_u32 vcc, 0, v52
  s_nop 4
  s_and_b32 s4, vcc_lo, 0xff
  s_cbranch_scc0 L_fenter
  s_add_u32 s73, s73, 1
  s_cmp_le_u32 s73, 120
  s_cbranch_scc1 L_chk0
  s_waitcnt lgkmcnt(0)
  buffer_store_dwordx4 v[92:95], v46, s[28:31], s66 offen offset:0 sc1
  buffer_store_dwordx4 v[96:99], v46, s[28:31], s66 offen offset:1024 sc1
  buffer_store_dwordx4 v[100:103], v46, s[28:31], s66 offen offset:2048 sc1
  s_mov_b32 exec_hi, 0
  buffer_store_dwordx4 v[104:107], v46, s[28:31], s66 offen offset:3072 sc1
  s_mov_b32 exec_hi, -1
  s_waitcnt vmcnt(0)
  s_memrealtime s[74:75]
  s_waitcnt lgkmcnt(0)
  v_mov_b32 v142, s74
  v_xor_b32 v143, s75, v141
  s_mov_b64 exec, 1
  buffer_store_dwordx2 v[142:143], v140, s[28:31], 0 offen offset:64
  s_mov_b64 exec, -1
  buffer_load_dwordx2 v[84:85], v40, s[16:19], s57 offen
  buffer_load_dwordx2 v[86:87], v40, s[20:23], s57 offen
  buffer_load_dwordx4 v[88:91], v41, s[24:27], s54 offen
  buffer_load_dwordx4 v[92:95], v32, s[12:15], s52 offen
  buffer_load_dwordx4 v[96:99], v33, s[12:15], s52 offen
  buffer_load_dwordx4 v[100:103], v34, s[12:15], s52 offen
  buffer_load_dwordx4 v[104:107], v35, s[12:15], s52 offen
  buffer_load_dwordx4 v[108:111], v36, s[12:15], s52 offen
  buffer_load_dwordx4 v[112:115], v37, s[12:15], s52 offen
  buffer_load_dwordx4 v[116:119], v38, s[12:15], s52 offen
  buffer_load_dwordx4 v[120:123], v39, s[12:15], s52 offen
  s_mov_b32 s55, 99
  s_mov_b32 s77, 99
  s_mov_b32 s78, 99
  s_mov_b32 s79, 99
  s_waitcnt vmcnt(0)
  s_branch L_ploop
L_fenter:
  s_add_u32 s4, s51, 0
  s_and_b32 s4, s4, 3
  s_lshl_b32 s4, s4, 14
  s_add_u32 m0, s4, s70
  s_lshl_b32 s5, s54, 7
  buffer_load_dwordx4 v46, s[28:31], s5 offen offset:0 sc1 lds
  buffer_load_dwordx4 v46, s[28:31], s5 offen offset:1024 sc1 lds
  buffer_load_dwordx4 v46, s[28:31], s5 offen offset:2048 sc1 lds
  s_mov_b32 exec_hi, 0
  buffer_load_dwordx4 v46, s[28:31], s5 offen offset:3072 sc1 lds
  s_mov_b32 exec_hi, -1
  s_cmp_eq_u32 s51, 15
  s_cbranch_scc1 L_flast
  s_branch L_floop
L_fb1:
  buffer_load_dwordx2 v[84:85], v40, s[16:19], s57 offen
  buffer_load_dwordx2 v[86:87], v40, s[20:23], s57 offen
  buffer_load_dwordx4 v[88:91], v41, s[24:27], s54 offen
  buffer_load_dwordx4 v[92:95], v32, s[12:15], s52 offen
  buffer_load_dwordx4 v[96:99], v33, s[12:15], s52 offen
  buffer_load_dwordx4 v[100:103], v34, s[12:15], s52 offen
  buffer_load_dwordx4 v[104:107], v35, s[12:15], s52 offen
  buffer_load_dwordx4 v[108:111], v36, s[12:15], s52 offen
  buffer_load_dwordx4 v[112:115], v37, s[12:15], s52 offen
  buffer_load_dwordx4 v[116:119], v38, s[12:15], s52 offen
  buffer_load_dwordx4 v[120:123], v39, s[12:15], s52 offen
  s_mov_b32 m0, s56
  s_nop 0
  buffer_load_dwordx4 v124, s[8:11], s54 offen offset:0  lds
  buffer_load_dwordx4 v125, s[8:11], s54 offen offset:1024  lds
  buffer_load_dwordx4 v126, s[8:11], s54 offen offset:2048  lds
  buffer_load_dwordx4 v127, s[8:11], s54 offen offset:3072  lds
  s_add_u32 m0, s56, 4096
  s_add_u32 s56, s56, 0x8000
  s_cmp_lt_u32 s56, s69
  s_cselect_b32 s56, s56, s68
  buffer_load_dwordx4 v128, s[8:11], s54 offen offset:0  lds
  buffer_load_dwordx4 v129, s[8:11], s54 offen offset:1024  lds
  buffer_load_dwordx4 v130, s[8:11], s54 offen offset:2048  lds
  buffer_load_dwordx4 v131, s[8:11], s54 offen offset:3072  lds
  s_waitcnt vmcnt(0)
  s_barrier
  s_add_u32 s51, s51, 1
L_ploop:
  s_and_b32 s4, s51, 3
  s_lshl_b32 s4, s4, 14
  v_add_u32 v132, s4, v28
  v_lshlrev_b32 v64, 16, v84
  v_and_b32 v65, v42, v84
  v_lshlrev_b32 v80, 16, v86
  v_and_b32 v81, v42, v86
  v_lshlrev_b32 v66, 16, v85
  v_and_b32 v67, v42, v85
  v_lshlrev_b32 v82, 16, v87
  v_and_b32 v83, v42, v87
  v_lshlrev_b32 v72, 16, v88
  v_and_b32 v73, v42, v88
  v_lshlrev_b32 v74, 16, v89
  v_and_b32 v75, v42, v89
  v_lshlrev_b32 v76, 16, v90
  v_and_b32 v77, v42, v90
  v_lshlrev_b32 v78, 16, v91
  v_and_b32 v79, v42, v91
  v_mul_f32_e64 v68, -v80, v64
  v_mul_f32_e64 v69, -v81, v65
  v_mul_f32_e64 v70, -v82, v66
  v_mul_f32_e64 v71, -v83, v67
  v_cvt_f32_i32 v144, v92
  v_cvt_f32_i32 v145, v93
  v_cvt_f32_i32 v146, v94
  v_cvt_f32_i32 v147, v95
  v_cvt_f32_i32 v148, v96
  v_cvt_f32_i32 v149, v97
  v_cvt_f32_i32 v150, v98
  v_cvt_f32_i32 v151, v99
  v_cvt_f32_i32 v152, v100
  v_cvt_f32_i32 v153, v101
  v_cvt_f32_i32 v154, v102
  v_cvt_f32_i32 v155, v103
  v_cvt_f32_i32 v156, v104
  v_cvt_f32_i32 v157, v105
  v_cvt_f32_i32 v158, v106
  v_cvt_f32_i32 v159, v107
  v_cvt_f32_i32 v160, v108
  v_cvt_f32_i32 v161, v109
  v_cvt_f32_i32 v162, v110
  v_cvt_f32_i32 v163, v111
  v_cvt_f32_i32 v164, v112
  v_cvt_f32_i32 v165, v113
  v_cvt_f32_i32 v166, v114
  v_cvt_f32_i32 v167, v115
  v_cvt_f32_i32 v168, v116
  v_cvt_f32_i32 v169, v117
  v_cvt_f32_i32 v170, v118
  v_cvt_f32_i32 v171, v119
  v_cvt_f32_i32 v172, v120
  v_cvt_f32_i32 v173, v121
  v_cvt_f32_i32 v174, v122
  v_cvt_f32_i32 v175, v123
  s_cmp_eq_u32 s51, 15
  s_cbranch_scc1 L_pnold
  s_add_u32 s57, s58, s50
  s_and_b32 s57, s57, 15
  s_lshr_b64 s[58:59], s[58:59], 4
  s_mul_i32 s52, s57, 917504
  s_lshl_b32 s54, s57, 7
  s_mul_i32 s57, s57, 14336
  s_mov_b32 m0, s56
  s_nop 0
  buffer_load_dwordx4 v124, s[8:11], s54 offen offset:0  lds
  buffer_load_dwordx4 v125, s[8:11], s54 offen offset:1024  lds
  buffer_load_dwordx4 v126, s[8:11], s54 offen offset:2048  lds
  buffer_load_dwordx4 v127, s[8:11], s54 offen offset:3072  lds
  s_add_u32 m0, s56, 4096
  s_add_u32 s56, s56, 0x8000
  s_cmp_lt_u32 s56, s69
  s_cselect_b32 s56, s56, s68
  buffer_load_dwordx4 v128, s[8:11], s54 offen offset:0  lds
  buffer_load_dwordx4 v129, s[8:11], s54 offen offset:1024  lds
  buffer_load_dwordx4 v130, s[8:11], s54 offen offset:2048  lds
  buffer_load_dwordx4 v131, s[8:11], s54 offen offset:3072  lds
  buffer_load_dwordx2 v[84:85], v40, s[16:19], s57 offen
  buffer_load_dwordx2 v[86:87], v40, s[20:23], s57 offen
  buffer_load_dwordx4 v[88:91], v41, s[24:27], s54 offen
  buffer_load_dwordx4 v[92:95], v32, s[12:15], s52 offen
  buffer_load_dwordx4 v[96:99], v33, s[12:15], s52 offen
  buffer_load_dwordx4 v[100:103], v34, s[12:15], s52 offen
  buffer_load_dwordx4 v[104:107], v35, s[12:15], s52 offen
  buffer_load_dwordx4 v[108:111], v36, s[12:15], s52 offen
  buffer_load_dwordx4 v[112:115], v37, s[12:15], s52 offen
  buffer_load_dwordx4 v[116:119], v38, s[12:15], s52 offen
  buffer_load_dwordx4 v[120:123], v39, s[12:15], s52 offen
  buffer_load_dwordx2 v[50:51], v43, s[28:31], 0 offen sc1
L_pnold:
  v_fma_f32 v144, v144, v64, v68
  v_fma_f32 v148, v148, v64, v68
  v_fma_f32 v152, v152, v64, v68
  v_fma_f32 v156, v156, v64, v68
  v_fma_f32 v160, v160, v64, v68
  v_fma_f32 v164, v164, v64, v68
  v_fma_f32 v168, v168, v64, v68
  v_fma_f32 v172, v172, v64, v68
  v_mul_f32 v144, v144, v72
  v_mul_f32 v148, v148, v73
  v_mul_f32 v152, v152, v74
  v_mul_f32 v156, v156, v75
  v_mul_f32 v160, v160, v76
  v_mul_f32 v164, v164, v77
  v_mul_f32 v168, v168, v78
  v_mul_f32 v172, v172, v79
  v_cvt_pk_bf16_f32 v8, v144, v148
  v_cvt_pk_bf16_f32 v9, v152, v156
  v_cvt_pk_bf16_f32 v10, v160, v164
  v_cvt_pk_bf16_f32 v11, v168, v172
  ds_write_b128 v132, v[8:11] offset:0
  v_fma_f32 v145, v145, v65, v69
  v_fma_f32 v149, v149, v65, v69
  v_fma_f32 v153, v153, v65, v69
  v_fma_f32 v157, v157, v65, v69
  v_fma_f32 v161, v161, v65, v69
  v_fma_f32 v165, v165, v65, v69
  v_fma_f32 v169, v169, v65, v69
  v_fma_f32 v173, v173, v65, v69
  v_mul_f32 v145, v145, v72
  v_mul_f32 v149, v149, v73
  v_mul_f32 v153, v153, v74
  v_mul_f32 v157, v157, v75
  v_mul_f32 v161, v161, v76
  v_mul_f32 v165, v165, v77
  v_mul_f32 v169, v169, v78
  v_mul_f32 v173, v173, v79
  v_cvt_pk_bf16_f32 v12, v145, v149
  v_cvt_pk_bf16_f32 v13, v153, v157
  v_cvt_pk_bf16_f32 v14, v161, v165
  v_cvt_pk_bf16_f32 v15, v169, v173
  ds_write_b128 v132, v[12:15] offset:448
  v_fma_f32 v146, v146, v66, v70
  v_fma_f32 v150, v150, v66, v70
  v_fma_f32 v154, v154, v66, v70
  v_fma_f32 v158, v158, v66, v70
  v_fma_f32 v162, v162, v66, v70
  v_fma_f32 v166, v166, v66, v70
  v_fma_f32 v170, v170, v66, v70
  v_fma_f32 v174, v174, v66, v70
  v_mul_f32 v146, v146, v72
  v_mul_f32 v150, v150, v73
  v_mul_f32 v154, v154, v74
  v_mul_f32 v158, v158, v75
  v_mul_f32 v162, v162, v76
  v_mul_f32 v166, v166, v77
  v_mul_f32 v170, v170, v78
  v_mul_f32 v174, v174, v79
  v_cvt_pk_bf16_f32 v16, v146, v150
  v_cvt_pk_bf16_f32 v17, v154, v158
  v_cvt_pk_bf16_f32 v18, v162, v166
  v_cvt_pk_bf16_f32 v19, v170, v174
  ds_write_b128 v132, v[16:19] offset:896
  v_fma_f32 v147, v147, v67, v71
  v_fma_f32 v151, v151, v67, v71
  v_fma_f32 v155, v155, v67, v71
  v_fma_f32 v159, v159, v67, v71
  v_fma_f32 v163, v163, v67, v71
  v_fma_f32 v167, v167, v67, v71
  v_fma_f32 v171, v171, v67, v71
  v_fma_f32 v175, v175, v67, v71
  v_mul_f32 v147, v147, v72
  v_mul_f32 v151, v151, v73
  v_mul_f32 v155, v155, v74
  v_mul_f32 v159, v159, v75
  v_mul_f32 v163, v163, v76
  v_mul_f32 v167, v167, v77
  v_mul_f32 v171, v171, v78
  v_mul_f32 v175, v175, v79
  v_cvt_pk_bf16_f32 v20, v147, v151
  v_cvt_pk_bf16_f32 v21, v155, v159
  v_cvt_pk_bf16_f32 v22, v163, v167
  v_cvt_pk_bf16_f32 v23, v171, v175
  ds_write_b128 v132, v[20:23] offset:1344
  s_waitcnt lgkmcnt(0)
  s_barrier
  s_add_u32 s51, s51, 1
  s_cmp_eq_u32 s51, 16
  s_cbranch_scc1 L_pend
  s_waitcnt vmcnt(0)
  v_sub_co_u32 v52, vcc, v50, v48
  v_xor_b32 v53, v51, v141
  s_nop 0
  v_subb_co_u32 v53, vcc, v53, v49, vcc
  v_lshrrev_b32 v52, 24, v52
  v_or_b32 v52, v52, v53
  v_cmp_ne_u32 vcc, 0, v52
  s_nop 4
  s_and_b32 s4, vcc_lo, 0xffff
  s_cbranch_scc1 L_ploop
  s_branch L_fenter
L_csetup:
  v_and_b32 v55, 15, v0
  v_lshrrev_b32 v56, 4, v0
  s_lshl_b32 s4, s3, 6
  v_add_u32 v124, s4, v55
  v_lshlrev_b32 v124, 7, v124
  v_lshrrev_b32 v57, 1, v55
  v_xor_b32 v57, v57, v56
  v_lshl_add_u32 v124, v57, 4, v124
  v_mov_b32 v125, v124
  v_xor_b32 v126, 64, v124
  v_mul_u32_u24 v57, 1792, v56
  v_add_u32 v57, 0x18000, v57
  v_lshl_add_u32 v128, v55, 4, v57
  v_and_b32 v58, 3, v55
  v_mul_u32_u24 v58, 448, v58
  v_lshrrev_b32 v59, 2, v55
  v_lshl_add_u32 v58, v59, 4, v58
  v_add_u32 v129, v57, v58
  v_mov_b32 v132, v128
  v_mov_b32 v133, v129
  s_lshl_b32 s5, s3, 13
  s_add_u32 s5, s5, 0x8000
  v_mul_u32_u24 v136, 960, v56
  v_lshl_add_u32 v136, v55, 3, v136
  v_add_u32 v136, s5, v136
  v_mul_u32_u24 v137, 240, v55
  v_lshl_add_u32 v137, v56, 3, v137
  v_add_u32 v137, s5, v137
  s_lshl_b32 s72, s7, 1
  s_add_u32 s72, s72, 8
  s_add_u32 s4, s4, s48
  s_lshl_b32 s73, s49, 1
  v_min_u32 v59, 47, v0
  v_mul_u32_u24 v57, 10923, v59
  v_lshrrev_b32 v57, 16, v57
  v_mul_u32_u24 v58, 6, v57
  v_sub_u32 v58, v59, v58
  v_mul_u32_u24 v127, 240, v57
  v_lshl_add_u32 v127, v58, 4, v127
  v_add_u32 v127, s5, v127
  v_add_u32 v58, s72, v58
  v_subrev_u32 v59, 14, v58
  v_min_u32 v58, v58, v59
  v_add_u32 v143, s4, v57
  v_mul_u32_u24 v143, 7168, v143
  v_lshl_add_u32 v143, v58, 4, v143
  v_cmp_lt_u32 vcc, 47, v0
  v_add_u32 v143, s73, v143
  v_mov_b32 v57, 0x40000000
  v_cndmask_b32 v143, v143, v57, vcc
  v_lshrrev_b32 v57, 4, v0
  v_lshl_add_u32 v139, v57, 2, s4
  v_mul_u32_u24 v139, 7168, v139
  v_and_b32 v57, 15, v0
  v_lshl_add_u32 v139, v57, 3, v139
  s_lshl_b32 s72, s7, 5
  s_add_u32 s73, s73, s72
  v_add_u32 v139, s73, v139
  v_mov_b64 v[144:145], 0
  v_mov_b64 v[146:147], 0
  v_mov_b64 v[148:149], 0
  v_mov_b64 v[150:151], 0
  v_mov_b64 v[152:153], 0
  v_mov_b64 v[154:155], 0
  v_mov_b64 v[156:157], 0
  v_mov_b64 v[158:159], 0
  v_mov_b64 v[160:161], 0
  v_mov_b64 v[162:163], 0
  v_mov_b64 v[164:165], 0
  v_mov_b64 v[166:167], 0
  v_mov_b64 v[168:169], 0
  v_mov_b64 v[170:171], 0
  v_mov_b64 v[172:173], 0
  v_mov_b64 v[174:175], 0
  v_mov_b64 v[176:177], 0
  v_mov_b64 v[178:179], 0
  v_mov_b64 v[180:181], 0
  v_mov_b64 v[182:183], 0
  v_mov_b64 v[184:185], 0
  v_mov_b64 v[186:187], 0
  v_mov_b64 v[188:189], 0
  v_mov_b64 v[190:191], 0
  v_mov_b64 v[192:193], 0
  v_mov_b64 v[194:195], 0
  v_mov_b64 v[196:197], 0
  v_mov_b64 v[198:199], 0
  v_mov_b64 v[200:201], 0
  v_mov_b64 v[202:203], 0
  v_mov_b64 v[204:205], 0
  v_mov_b64 v[206:207], 0
  v_mov_b64 v[208:209], 0
  v_mov_b64 v[210:211], 0
  v_mov_b64 v[212:213], 0
  v_mov_b64 v[214:215], 0
  v_mov_b64 v[216:217], 0
  v_mov_b64 v[218:219], 0
  v_mov_b64 v[220:221], 0
  v_mov_b64 v[222:223], 0
  v_mov_b64 v[224:225], 0
  v_mov_b64 v[226:227], 0
  v_mov_b64 v[228:229], 0
  v_mov_b64 v[230:231], 0
  v_mov_b64 v[232:233], 0
  v_mov_b64 v[234:235], 0
  v_mov_b64 v[236:237], 0
  v_mov_b64 v[238:239], 0
  v_mov_b64 v[240:241], 0
  v_mov_b64 v[242:243], 0
  v_mov_b64 v[244:245], 0
  v_mov_b64 v[246:247], 0
  v_mov_b64 v[248:249], 0
  v_mov_b64 v[250:251], 0
  v_mov_b64 v[252:253], 0
  v_mov_b64 v[254:255], 0
  s_mov_b32 s8, s42
  s_and_b32 s9, s43, 0xffff
  s_mov_b32 s10, 14680064
  s_mov_b32 s11, 0x20000
  s_mov_b32 s51, 0
  s_mov_b32 s54, 0
  s_mov_b32 s55, 0
  s_branch L_own
.p2align 6
L_consumer:
  s_waitcnt lgkmcnt(0)
  s_barrier
  ds_read_b128 v[32:35], v125 offset:0
  ds_read_b128 v[48:51], v132 offset:0
  ds_read_b128 v[52:55], v132 offset:448
  ds_read_b128 v[56:59], v132 offset:896
  ds_read_b128 v[60:63], v132 offset:1344
  ds_read_b128 v[64:67], v133 offset:256
  ds_read_b128 v[68:71], v133 offset:320
  ds_read_b128 v[72:75], v133 offset:384
  ds_read_b128 v[36:39], v125 offset:2048
  ds_read_b128 v[40:43], v125 offset:4096
  ds_read_b128 v[44:47], v125 offset:6144
  s_waitcnt lgkmcnt(0)
.p2align 6
L_cloop:
  v_mfma_f32_16x16x32_bf16 v[144:147], v[32:35], v[48:51], v[144:147]
  ds_read_b128 v[80:83], v126 offset:0
  v_mfma_f32_16x16x32_bf16 v[148:151], v[32:35], v[52:55], v[148:151]
  v_mfma_f32_16x16x32_bf16 v[152:155], v[32:35], v[56:59], v[152:155]
  ds_read_b128 v[96:99], v132 offset:7168
  v_mfma_f32_16x16x32_bf16 v[156:159], v[32:35], v[60:63], v[156:159]
  v_mfma_f32_16x16x32_bf16 v[160:163], v[64:67], v[32:35], v[160:163]
  ds_read_b128 v[100:103], v132 offset:7616
  v_mfma_f32_16x16x32_bf16 v[164:167], v[68:71], v[32:35], v[164:167]
  v_mfma_f32_16x16x32_bf16 v[168:171], v[72:75], v[32:35], v[168:171]
  ds_read_b128 v[104:107], v132 offset:8064
  v_mfma_f32_16x16x32_bf16 v[172:175], v[36:39], v[48:51], v[172:175]
  v_mfma_f32_16x16x32_bf16 v[176:179], v[36:39], v[52:55], v[176:179]
  ds_read_b128 v[108:111], v132 offset:8512
  v_mfma_f32_16x16x32_bf16 v[180:183], v[36:39], v[56:59], v[180:183]
  v_mfma_f32_16x16x32_bf16 v[184:187], v[36:39], v[60:63], v[184:187]
  ds_read_b128 v[112:115], v133 offset:7424
  v_mfma_f32_16x16x32_bf16 v[188:191], v[64:67], v[36:39], v[188:191]
  v_mfma_f32_16x16x32_bf16 v[192:195], v[68:71], v[36:39], v[192:195]
  ds_read_b128 v[116:119], v133 offset:7488
  v_mfma_f32_16x16x32_bf16 v[196:199], v[72:75], v[36:39], v[196:199]
  v_mfma_f32_16x16x32_bf16 v[200:203], v[40:43], v[48:51], v[200:203]
  ds_read_b128 v[120:123], v133 offset:7552
  v_mfma_f32_16x16x32_bf16 v[204:207], v[40:43], v[52:55], v[204:207]
  v_mfma_f32_16x16x32_bf16 v[208:211], v[40:43], v[56:59], v[208:211]
  ds_read_b128 v[84:87], v126 offset:2048
  v_mfma_f32_16x16x32_bf16 v[212:215], v[40:43], v[60:63], v[212:215]
  v_mfma_f32_16x16x32_bf16 v[216:219], v[64:67], v[40:43], v[216:219]
  ds_read_b128 v[88:91], v126 offset:4096
  v_mfma_f32_16x16x32_bf16 v[220:223], v[68:71], v[40:43], v[220:223]
  v_mfma_f32_16x16x32_bf16 v[224:227], v[72:75], v[40:43], v[224:227]
  ds_read_b128 v[92:95], v126 offset:6144
  v_mfma_f32_16x16x32_bf16 v[228:231], v[44:47], v[48:51], v[228:231]
  v_mfma_f32_16x16x32_bf16 v[232:235], v[44:47], v[52:55], v[232:235]
  s_add_u32 s54, s54, 0x8000
  s_cmp_lt_u32 s54, 0x18000
  s_cselect_b32 s54, s54, 0
  v_mfma_f32_16x16x32_bf16 v[236:239], v[44:47], v[56:59], v[236:239]
  s_add_u32 s55, s55, 0x4000
  s_and_b32 s55, s55, 0xffff
  v_add_u32 v125, s54, v124
  v_mfma_f32_16x16x32_bf16 v[240:243], v[44:47], v[60:63], v[240:243]
  v_add_u32 v132, s55, v128
  v_add_u32 v133, s55, v129
  v_mfma_f32_16x16x32_bf16 v[244:247], v[64:67], v[44:47], v[244:247]
  v_xor_b32 v126, 64, v125
  s_cmp_eq_u32 s51, 14
  v_mfma_f32_16x16x32_bf16 v[248:251], v[68:71], v[44:47], v[248:251]
  v_mfma_f32_16x16x32_bf16 v[252:255], v[72:75], v[44:47], v[252:255]
  s_cbranch_scc1 L_final
  s_waitcnt lgkmcnt(0)
  s_barrier
  v_mfma_f32_16x16x32_bf16 v[144:147], v[80:83], v[96:99], v[144:147]
  ds_read_b128 v[32:35], v125 offset:0
  v_mfma_f32_16x16x32_bf16 v[148:151], v[80:83], v[100:103], v[148:151]
  v_mfma_f32_16x16x32_bf16 v[152:155], v[80:83], v[104:107], v[152:155]
  ds_read_b128 v[48:51], v132 offset:0
  v_mfma_f32_16x16x32_bf16 v[156:159], v[80:83], v[108:111], v[156:159]
  v_mfma_f32_16x16x32_bf16 v[160:163], v[112:115], v[80:83], v[160:163]
  ds_read_b128 v[52:55], v132 offset:448
  v_mfma_f32_16x16x32_bf16 v[164:167], v[116:119], v[80:83], v[164:167]
  v_mfma_f32_16x16x32_bf16 v[168:171], v[120:123], v[80:83], v[168:171]
  ds_read_b128 v[56:59], v132 offset:896
  v_mfma_f32_16x16x32_bf16 v[172:175], v[84:87], v[96:99], v[172:175]
  v_mfma_f32_16x16x32_bf16 v[176:179], v[84:87], v[100:103], v[176:179]
  ds_read_b128 v[60:63], v132 offset:1344
  v_mfma_f32_16x16x32_bf16 v[180:183], v[84:87], v[104:107], v[180:183]
  v_mfma_f32_16x16x32_bf16 v[184:187], v[84:87], v[108:111], v[184:187]
  ds_read_b128 v[64:67], v133 offset:256
  v_mfma_f32_16x16x32_bf16 v[188:191], v[112:115], v[84:87], v[188:191]
  v_mfma_f32_16x16x32_bf16 v[192:195], v[116:119], v[84:87], v[192:195]
  ds_read_b128 v[68:71], v133 offset:320
  v_mfma_f32_16x16x32_bf16 v[196:199], v[120:123], v[84:87], v[196:199]
  v_mfma_f32_16x16x32_bf16 v[200:203], v[88:91], v[96:99], v[200:203]
  ds_read_b128 v[72:75], v133 offset:384
  v_mfma_f32_16x16x32_bf16 v[204:207], v[88:91], v[100:103], v[204:207]
  v_mfma_f32_16x16x32_bf16 v[208:211], v[88:91], v[104:107], v[208:211]
  ds_read_b128 v[36:39], v125 offset:2048
  v_mfma_f32_16x16x32_bf16 v[212:215], v[88:91], v[108:111], v[212:215]
  v_mfma_f32_16x16x32_bf16 v[216:219], v[112:115], v[88:91], v[216:219]
  ds_read_b128 v[40:43], v125 offset:4096
  v_mfma_f32_16x16x32_bf16 v[220:223], v[116:119], v[88:91], v[220:223]
  v_mfma_f32_16x16x32_bf16 v[224:227], v[120:123], v[88:91], v[224:227]
  ds_read_b128 v[44:47], v125 offset:6144
  v_mfma_f32_16x16x32_bf16 v[228:231], v[92:95], v[96:99], v[228:231]
  v_mfma_f32_16x16x32_bf16 v[232:235], v[92:95], v[100:103], v[232:235]
  v_mfma_f32_16x16x32_bf16 v[236:239], v[92:95], v[104:107], v[236:239]
  v_mfma_f32_16x16x32_bf16 v[240:243], v[92:95], v[108:111], v[240:243]
  v_mfma_f32_16x16x32_bf16 v[244:247], v[112:115], v[92:95], v[244:247]
  v_mfma_f32_16x16x32_bf16 v[248:251], v[116:119], v[92:95], v[248:251]
  v_mfma_f32_16x16x32_bf16 v[252:255], v[120:123], v[92:95], v[252:255]
  s_add_u32 s51, s51, 1
  s_waitcnt lgkmcnt(0)
  s_branch L_cloop
.p2align 6
L_final:
  s_waitcnt lgkmcnt(0)
  s_barrier
  v_mfma_f32_16x16x32_bf16 v[160:163], v[112:115], v[80:83], v[160:163]
  ds_read_b128 v[32:35], v125 offset:0
  v_mfma_f32_16x16x32_bf16 v[164:167], v[116:119], v[80:83], v[164:167]
  ds_read_b128 v[64:67], v133 offset:256
  v_mfma_f32_16x16x32_bf16 v[168:171], v[120:123], v[80:83], v[168:171]
  ds_read_b128 v[68:71], v133 offset:320
  v_mfma_f32_16x16x32_bf16 v[144:147], v[80:83], v[96:99], v[144:147]
  ds_read_b128 v[72:75], v133 offset:384
  v_mfma_f32_16x16x32_bf16 v[148:151], v[80:83], v[100:103], v[148:151]
  ds_read_b128 v[48:51], v132 offset:0
  v_mfma_f32_16x16x32_bf16 v[152:155], v[80:83], v[104:107], v[152:155]
  ds_read_b128 v[52:55], v132 offset:448
  v_mfma_f32_16x16x32_bf16 v[156:159], v[80:83], v[108:111], v[156:159]
  ds_read_b128 v[56:59], v132 offset:896
  v_mfma_f32_16x16x32_bf16 v[188:191], v[112:115], v[84:87], v[188:191]
  ds_read_b128 v[60:63], v132 offset:1344
  v_mfma_f32_16x16x32_bf16 v[192:195], v[116:119], v[84:87], v[192:195]
  ds_read_b128 v[80:83], v126 offset:0
  v_mfma_f32_16x16x32_bf16 v[196:199], v[120:123], v[84:87], v[196:199]
  ds_read_b128 v[24:27], v133 offset:7424
  v_mfma_f32_16x16x32_bf16 v[172:175], v[84:87], v[96:99], v[172:175]
  ds_read_b128 v[28:31], v133 offset:7488
  v_mfma_f32_16x16x32_bf16 v[176:179], v[84:87], v[100:103], v[176:179]
  ds_read_b128 v[76:79], v133 offset:7552
  v_mfma_f32_16x16x32_bf16 v[180:183], v[84:87], v[104:107], v[180:183]
  ds_read_b128 v[8:11], v132 offset:7168
  v_mfma_f32_16x16x32_bf16 v[184:187], v[84:87], v[108:111], v[184:187]
  ds_read_b128 v[12:15], v132 offset:7616
  s_waitcnt lgkmcnt(6)
  v_mfma_f32_16x16x32_bf16 v[160:163], v[64:67], v[32:35], v[160:163]
  ds_read_b128 v[16:19], v132 offset:8064
  v_mfma_f32_16x16x32_bf16 v[164:167], v[68:71], v[32:35], v[164:167]
  ds_read_b128 v[20:23], v132 offset:8512
  v_mfma_f32_16x16x32_bf16 v[168:171], v[72:75], v[32:35], v[168:171]
  ds_read_b128 v[36:39], v125 offset:2048
  v_mfma_f32_16x16x32_bf16 v[144:147], v[32:35], v[48:51], v[144:147]
  ds_read_b128 v[84:87], v126 offset:2048
  v_mfma_f32_16x16x32_bf16 v[148:151], v[32:35], v[52:55], v[148:151]
  ds_read_b128 v[40:43], v125 offset:4096
  v_mfma_f32_16x16x32_bf16 v[152:155], v[32:35], v[56:59], v[152:155]
  ds_read_b128 v[44:47], v125 offset:6144
  v_mfma_f32_16x16x32_bf16 v[156:159], v[32:35], v[60:63], v[156:159]
  s_waitcnt lgkmcnt(4)
  v_mfma_f32_16x16x32_bf16 v[160:163], v[24:27], v[80:83], v[160:163]
  v_mfma_f32_16x16x32_bf16 v[164:167], v[28:31], v[80:83], v[164:167]
  ds_read_b128 v[32:35], v126 offset:4096
  v_mfma_f32_16x16x32_bf16 v[168:171], v[76:79], v[80:83], v[168:171]
  v_mfma_f32_16x16x32_bf16 v[144:147], v[80:83], v[8:11], v[144:147]
  v_mfma_f32_16x16x32_bf16 v[148:151], v[80:83], v[12:15], v[148:151]
  v_mfma_f32_16x16x32_bf16 v[152:155], v[80:83], v[16:19], v[152:155]
  v_mfma_f32_16x16x32_bf16 v[156:159], v[80:83], v[20:23], v[156:159]
  s_waitcnt lgkmcnt(4)
  v_mfma_f32_16x16x32_bf16 v[188:191], v[64:67], v[36:39], v[188:191]
  v_mfma_f32_16x16x32_bf16 v[192:195], v[68:71], v[36:39], v[192:195]
  ds_read_b128 v[80:83], v126 offset:6144
  v_mfma_f32_16x16x32_bf16 v[196:199], v[72:75], v[36:39], v[196:199]
  v_cvt_pk_bf16_f32 v160, v160, v161
  v_cvt_pk_bf16_f32 v161, v162, v163
  v_mfma_f32_16x16x32_bf16 v[172:175], v[36:39], v[48:51], v[172:175]
  ds_write_b64 v137, v[160:161] offset:128
  v_mfma_f32_16x16x32_bf16 v[176:179], v[36:39], v[52:55], v[176:179]
  v_cvt_pk_bf16_f32 v164, v164, v165
  v_cvt_pk_bf16_f32 v165, v166, v167
  v_mfma_f32_16x16x32_bf16 v[180:183], v[36:39], v[56:59], v[180:183]
  ds_write_b64 v137, v[164:165] offset:160
  v_mfma_f32_16x16x32_bf16 v[184:187], v[36:39], v[60:63], v[184:187]
  v_cvt_pk_bf16_f32 v168, v168, v169
  v_cvt_pk_bf16_f32 v169, v170, v171
  s_waitcnt lgkmcnt(6)
  v_mfma_f32_16x16x32_bf16 v[188:191], v[24:27], v[84:87], v[188:191]
  ds_write_b64 v137, v[168:169] offset:192
  v_mfma_f32_16x16x32_bf16 v[192:195], v[28:31], v[84:87], v[192:195]
  v_cvt_pk_bf16_f32 v162, v144, v148
  v_cvt_pk_bf16_f32 v163, v152, v156
  v_mfma_f32_16x16x32_bf16 v[196:199], v[76:79], v[84:87], v[196:199]
  s_mov_b32 s4, 0
  buffer_store_dwordx2 v[162:163], v139, s[8:11], s4 offen nt
  v_mfma_f32_16x16x32_bf16 v[172:175], v[84:87], v[8:11], v[172:175]
  v_cvt_pk_bf16_f32 v166, v145, v149
  v_mfma_f32_16x16x32_bf16 v[176:179], v[84:87], v[12:15], v[176:179]
  v_cvt_pk_bf16_f32 v167, v153, v157
  s_mov_b32 s4, 7168
  buffer_store_dwordx2 v[166:167], v139, s[8:11], s4 offen nt
  s_waitcnt lgkmcnt(0)
  s_barrier
  v_mfma_f32_16x16x32_bf16 v[180:183], v[84:87], v[16:19], v[180:183]
  v_cvt_pk_bf16_f32 v170, v146, v150
  v_mfma_f32_16x16x32_bf16 v[184:187], v[84:87], v[20:23], v[184:187]
  v_cvt_pk_bf16_f32 v171, v154, v158
  v_mfma_f32_16x16x32_bf16 v[216:219], v[112:115], v[88:91], v[216:219]
  s_mov_b32 s4, 14336
  buffer_store_dwordx2 v[170:171], v139, s[8:11], s4 offen nt
  v_cvt_pk_bf16_f32 v144, v147, v151
  v_mfma_f32_16x16x32_bf16 v[220:223], v[116:119], v[88:91], v[220:223]
  v_cvt_pk_bf16_f32 v145, v155, v159
  v_mfma_f32_16x16x32_bf16 v[224:227], v[120:123], v[88:91], v[224:227]
  s_mov_b32 s4, 21504
  buffer_store_dwordx2 v[144:145], v139, s[8:11], s4 offen nt
  v_mfma_f32_16x16x32_bf16 v[200:203], v[88:91], v[96:99], v[200:203]
  v_mfma_f32_16x16x32_bf16 v[204:207], v[88:91], v[100:103], v[204:207]
  v_cvt_pk_bf16_f32 v188, v188, v189
  v_cvt_pk_bf16_f32 v189, v190, v191
  v_mfma_f32_16x16x32_bf16 v[208:211], v[88:91], v[104:107], v[208:211]
  ds_write_b64 v137, v[188:189] offset:3968
  v_mfma_f32_16x16x32_bf16 v[212:215], v[88:91], v[108:111], v[212:215]
  v_cvt_pk_bf16_f32 v192, v192, v193
  v_cvt_pk_bf16_f32 v193, v194, v195
  s_waitcnt lgkmcnt(7)
  v_mfma_f32_16x16x32_bf16 v[216:219], v[64:67], v[40:43], v[216:219]
  ds_write_b64 v137, v[192:193] offset:4000
  v_mfma_f32_16x16x32_bf16 v[220:223], v[68:71], v[40:43], v[220:223]
  v_cvt_pk_bf16_f32 v196, v196, v197
  v_cvt_pk_bf16_f32 v197, v198, v199
  v_mfma_f32_16x16x32_bf16 v[224:227], v[72:75], v[40:43], v[224:227]
  ds_write_b64 v137, v[196:197] offset:4032
  v_mfma_f32_16x16x32_bf16 v[200:203], v[40:43], v[48:51], v[200:203]
  v_cvt_pk_bf16_f32 v190, v172, v176
  v_cvt_pk_bf16_f32 v191, v180, v184
  v_mfma_f32_16x16x32_bf16 v[204:207], v[40:43], v[52:55], v[204:207]
  s_mov_b32 s4, 114688
  buffer_store_dwordx2 v[190:191], v139, s[8:11], s4 offen nt
  v_mfma_f32_16x16x32_bf16 v[208:211], v[40:43], v[56:59], v[208:211]
  v_cvt_pk_bf16_f32 v194, v173, v177
  v_mfma_f32_16x16x32_bf16 v[212:215], v[40:43], v[60:63], v[212:215]
  v_cvt_pk_bf16_f32 v195, v181, v185
  s_mov_b32 s4, 121856
  buffer_store_dwordx2 v[194:195], v139, s[8:11], s4 offen nt
  s_waitcnt lgkmcnt(0)
  s_barrier
  s_waitcnt lgkmcnt(7)
  v_mfma_f32_16x16x32_bf16 v[216:219], v[24:27], v[32:35], v[216:219]
  v_cvt_pk_bf16_f32 v198, v174, v178
  v_mfma_f32_16x16x32_bf16 v[220:223], v[28:31], v[32:35], v[220:223]
  v_cvt_pk_bf16_f32 v199, v182, v186
  v_mfma_f32_16x16x32_bf16 v[224:227], v[76:79], v[32:35], v[224:227]
  s_mov_b32 s4, 129024
  buffer_store_dwordx2 v[198:199], v139, s[8:11], s4 offen nt
  v_cvt_pk_bf16_f32 v172, v175, v179
  v_mfma_f32_16x16x32_bf16 v[200:203], v[32:35], v[8:11], v[200:203]
  v_cvt_pk_bf16_f32 v173, v183, v187
  v_mfma_f32_16x16x32_bf16 v[204:207], v[32:35], v[12:15], v[204:207]
  s_mov_b32 s4, 136192
  buffer_store_dwordx2 v[172:173], v139, s[8:11], s4 offen nt
  v_mfma_f32_16x16x32_bf16 v[208:211], v[32:35], v[16:19], v[208:211]
  v_mfma_f32_16x16x32_bf16 v[212:215], v[32:35], v[20:23], v[212:215]
  v_mfma_f32_16x16x32_bf16 v[244:247], v[112:115], v[92:95], v[244:247]
  v_mfma_f32_16x16x32_bf16 v[248:251], v[116:119], v[92:95], v[248:251]
  v_mfma_f32_16x16x32_bf16 v[252:255], v[120:123], v[92:95], v[252:255]
  v_cvt_pk_bf16_f32 v216, v216, v217
  v_cvt_pk_bf16_f32 v217, v218, v219
  v_mfma_f32_16x16x32_bf16 v[228:231], v[92:95], v[96:99], v[228:231]
  ds_write_b64 v137, v[216:217] offset:32896
  v_mfma_f32_16x16x32_bf16 v[232:235], v[92:95], v[100:103], v[232:235]
  v_cvt_pk_bf16_f32 v220, v220, v221
  v_cvt_pk_bf16_f32 v221, v222, v223
  v_mfma_f32_16x16x32_bf16 v[236:239], v[92:95], v[104:107], v[236:239]
  ds_write_b64 v137, v[220:221] offset:32928
  v_mfma_f32_16x16x32_bf16 v[240:243], v[92:95], v[108:111], v[240:243]
  v_cvt_pk_bf16_f32 v224, v224, v225
  v_cvt_pk_bf16_f32 v225, v226, v227
  s_waitcnt lgkmcnt(10)
  v_mfma_f32_16x16x32_bf16 v[244:247], v[64:67], v[44:47], v[244:247]
  ds_write_b64 v137, v[224:225] offset:32960
  v_mfma_f32_16x16x32_bf16 v[248:251], v[68:71], v[44:47], v[248:251]
  v_cvt_pk_bf16_f32 v218, v200, v204
  v_cvt_pk_bf16_f32 v219, v208, v212
  v_mfma_f32_16x16x32_bf16 v[252:255], v[72:75], v[44:47], v[252:255]
  s_mov_b32 s4, 229376
  buffer_store_dwordx2 v[218:219], v139, s[8:11], s4 offen nt
  v_mfma_f32_16x16x32_bf16 v[228:231], v[44:47], v[48:51], v[228:231]
  v_cvt_pk_bf16_f32 v222, v201, v205
  v_mfma_f32_16x16x32_bf16 v[232:235], v[44:47], v[52:55], v[232:235]
  v_cvt_pk_bf16_f32 v223, v209, v213
  s_mov_b32 s4, 236544
  buffer_store_dwordx2 v[222:223], v139, s[8:11], s4 offen nt
  s_waitcnt lgkmcnt(0)
  s_barrier
  v_mfma_f32_16x16x32_bf16 v[236:239], v[44:47], v[56:59], v[236:239]
  v_cvt_pk_bf16_f32 v226, v202, v206
  v_mfma_f32_16x16x32_bf16 v[240:243], v[44:47], v[60:63], v[240:243]
  v_cvt_pk_bf16_f32 v227, v210, v214
  s_waitcnt lgkmcnt(9)
  v_mfma_f32_16x16x32_bf16 v[244:247], v[24:27], v[80:83], v[244:247]
  s_mov_b32 s4, 243712
  buffer_store_dwordx2 v[226:227], v139, s[8:11], s4 offen nt
  v_cvt_pk_bf16_f32 v200, v203, v207
  v_mfma_f32_16x16x32_bf16 v[248:251], v[28:31], v[80:83], v[248:251]
  v_cvt_pk_bf16_f32 v201, v211, v215
  v_mfma_f32_16x16x32_bf16 v[252:255], v[76:79], v[80:83], v[252:255]
  s_mov_b32 s4, 250880
  buffer_store_dwordx2 v[200:201], v139, s[8:11], s4 offen nt
  v_mfma_f32_16x16x32_bf16 v[228:231], v[80:83], v[8:11], v[228:231]
  v_mfma_f32_16x16x32_bf16 v[232:235], v[80:83], v[12:15], v[232:235]
  v_mfma_f32_16x16x32_bf16 v[236:239], v[80:83], v[16:19], v[236:239]
  v_mfma_f32_16x16x32_bf16 v[240:243], v[80:83], v[20:23], v[240:243]
  s_nop 3
  v_cvt_pk_bf16_f32 v244, v244, v245
  v_cvt_pk_bf16_f32 v245, v246, v247
  ds_write_b64 v137, v[244:245] offset:36736
  v_cvt_pk_bf16_f32 v248, v248, v249
  v_cvt_pk_bf16_f32 v249, v250, v251
  ds_write_b64 v137, v[248:249] offset:36768
  v_cvt_pk_bf16_f32 v252, v252, v253
  v_cvt_pk_bf16_f32 v253, v254, v255
  ds_write_b64 v137, v[252:253] offset:36800
  ds_read_b128 v[32:35], v127 offset:36736
  ds_read_b128 v[36:39], v127 offset:38656
  v_cvt_pk_bf16_f32 v246, v228, v232
  v_cvt_pk_bf16_f32 v247, v236, v240
  s_mov_b32 s4, 344064
  buffer_store_dwordx2 v[246:247], v139, s[8:11], s4 offen nt
  v_cvt_pk_bf16_f32 v250, v229, v233
  v_cvt_pk_bf16_f32 v251, v237, v241
  s_mov_b32 s4, 351232
  buffer_store_dwordx2 v[250:251], v139, s[8:11], s4 offen nt
  v_cvt_pk_bf16_f32 v254, v230, v234
  v_cvt_pk_bf16_f32 v255, v238, v242
  s_mov_b32 s4, 358400
  buffer_store_dwordx2 v[254:255], v139, s[8:11], s4 offen nt
  v_cvt_pk_bf16_f32 v228, v231, v235
  v_cvt_pk_bf16_f32 v229, v239, v243
  s_mov_b32 s4, 365568
  buffer_store_dwordx2 v[228:229], v139, s[8:11], s4 offen nt
  s_mov_b32 s4, 344064
  s_waitcnt lgkmcnt(1)
  buffer_store_dwordx4 v[32:35], v143, s[8:11], s4 offen
  s_mov_b32 s4, 401408
  s_waitcnt lgkmcnt(0)
  buffer_store_dwordx4 v[36:39], v143, s[8:11], s4 offen
L_code_end:
  s_endpgm
.section .rodata,"a"
.p2align 6
.amdhsa_kernel standalone__weight_only_int_omniquant__prompt_kernel
  .amdhsa_next_free_vgpr 256
  .amdhsa_next_free_sgpr 80
  .amdhsa_accum_offset 256
  .amdhsa_group_segment_fixed_size 0
  .amdhsa_kernarg_size 64
  .amdhsa_user_sgpr_count 2
  .amdhsa_user_sgpr_kernarg_segment_ptr 1
  .amdhsa_system_sgpr_workgroup_id_x 1
  .amdhsa_float_denorm_mode_32 3
.end_amdhsa_kernel
```
